```python
import torch

def _softmax(x, axis=-1):
    return torch.softmax(x, dim=axis)
def _gelu(x):
    return torch.nn.functional.gelu(x, approximate="tanh")
def _silu(x):
    return torch.nn.functional.silu(x)
def _sigmoid(x):
    return torch.sigmoid(x)
def _layernorm(x, axis=-1, eps=1e-5):
    m = x.mean(dim=axis, keepdim=True)
    v = x.var(dim=axis, keepdim=True, unbiased=False)
    return (x - m) / torch.sqrt(v + eps)
def _scatter_add(tgt, idx, src, axis=0):
    return tgt.clone().index_add_(axis, idx, src)
def _segment_sum(src, seg, n):
    out = torch.zeros((n,) + src.shape[1:], dtype=src.dtype)
    return out.index_add_(0, seg, src)
def _pad(x, pw):
    flat = tuple(v for pair in reversed(pw) for v in pair)
    return torch.nn.functional.pad(x, flat)

kernel_name = 'recurrent_scan__sliding_block_cached__swiglu_ffn__decode'

def setup_inputs():

    _w = (lambda a: (lambda t: t.to(torch.bfloat16) if t.is_floating_point() else t)(torch.as_tensor(a)))
    def _A_setup():
        B, Sq, D = 1, 1, 640
        Hq, Hkv, Sk, Dh = 32, 32, 32768, 128
        assert Hq % Hkv == 0, (Hq, Hkv)
        return {
            "x": _w((lambda *s: torch.randn(*s, dtype=torch.bfloat16) * 0.05)(B, Sq, D)),
            "k_cache": _w((lambda *s: torch.randn(*s, dtype=torch.bfloat16) * 1.6)(B, Hkv, Sk, Dh)),
            "v_cache": _w((lambda *s: torch.randn(*s, dtype=torch.bfloat16) * 0.2)(B, Hkv, Sk, Dh)),
            "wq": _w((lambda *s: torch.randn(*s, dtype=torch.bfloat16) * 1.6)(D, Hq * Dh) * (D ** -0.5)),
            "wo": _w((lambda *s: torch.randn(*s, dtype=torch.bfloat16) * 0.2)(Hq * Dh, D) * ((Hq * Dh) ** -0.5)),
        }
    _A_in = _A_setup()

    def _B_setup():
        B, S, D, F = 1, 1, 640, 1728
        return {
            "x": _w((lambda *s: torch.randn(*s, dtype=torch.bfloat16) * 0.05)(B, S, D)),
            "w_gate": _w((lambda *s: torch.randn(*s, dtype=torch.bfloat16) * 0.1)(D, F)),
            "w_up": _w((lambda *s: torch.randn(*s, dtype=torch.bfloat16) * 0.1)(D, F)),
            "w_down": _w((lambda *s: torch.randn(*s, dtype=torch.bfloat16) * 0.1)(F, D)),
        }
    _B_in = _B_setup()

    return {
        "A_x": _A_in["x"],
        "A_k_cache": _A_in["k_cache"],
        "A_v_cache": _A_in["v_cache"],
        "A_wq": _A_in["wq"],
        "A_wo": _A_in["wo"],
        "B_x": _B_in["x"],
        "B_w_gate": _B_in["w_gate"],
        "B_w_up": _B_in["w_up"],
        "B_w_down": _B_in["w_down"],
    }

def reference(A_x, A_k_cache, A_v_cache, A_wq, A_wo, B_x, B_w_gate, B_w_up, B_w_down):
    def _A_ref(x, k_cache, v_cache, wq, wo):
        B, Sq, D = x.shape
        Hq, Dh = 32, 128
        Hkv, Sk = k_cache.shape[1], k_cache.shape[2]
        W = min(4096, max(256, Sk // 4))
        rep = Hq // Hkv
        q = (lambda x, *d: x.permute(*d))((x @ wq).reshape(B, Sq, Hq, Dh), 0, 2, 1, 3)
        k = (lambda x, n, axis: torch.repeat_interleave(x, n, dim=axis))(k_cache[:, :, Sk - W:, :], rep, axis=1)
        v = (lambda x, n, axis: torch.repeat_interleave(x, n, dim=axis))(v_cache[:, :, Sk - W:, :], rep, axis=1)
        scores = torch.einsum("bhqd,bhkd->bhqk", q, k) * (Dh ** -0.5)
        p = _softmax(scores, axis=-1)
        o = torch.einsum("bhqk,bhkd->bhqd", p, v)
        return (lambda x, *d: x.permute(*d))(o, 0, 2, 1, 3).reshape(B, Sq, Hq * Dh) @ wo

    def _B_ref(x, w_gate, w_up, w_down):
        g = _silu(x @ w_gate)
        u = x @ w_up
        return (g * u) @ w_down

    x = A_x
    xn = _layernorm(x, axis=-1)
    s = _A_ref(xn, A_k_cache, A_v_cache, A_wq, A_wo)
    g = _silu(_B_ref(xn, B_w_gate, B_w_up, B_w_down))
    return x + s * g
```

```asm
; @launch grid=(256,1,1) block=(768,1,1) lds=6144
.amdgcn_target "amdgcn-amd-amdhsa--gfx950"
.text
.globl recurrent_scan__sliding_block_cached__swiglu_ffn__decode_kernel
.p2align 8
.type recurrent_scan__sliding_block_cached__swiglu_ffn__decode_kernel,@function
recurrent_scan__sliding_block_cached__swiglu_ffn__decode_kernel:
  s_cmp_ge_u32 s2, 256
  s_cbranch_scc1 L_end
  s_load_dwordx16 s[16:31], s[0:1], 0
  s_load_dwordx4 s[32:35], s[0:1], 64
  s_load_dwordx2 s[8:9], s[0:1], 88
  v_lshlrev_b32 v2, 7, v0
  s_getpc_b64 s[48:49]
L_pc:
  v_cmp_gt_u32 vcc, L_last-L_pc, v2
  s_nop 0
  s_and_saveexec_b64 s[50:51], vcc
  s_cbranch_execz L_nocpf
  global_load_dword v151, v2, s[48:49]
L_nocpf:
  s_mov_b64 exec, -1
  v_lshrrev_b32 v1, 6, v0
  v_and_b32 v0, 63, v0
  v_readfirstlane_b32 s3, v1
  v_lshlrev_b32 v1, 4, v0
  v_mov_b32 v7, 0
  s_bfe_u32 s5, s2, 0x30003
  s_lshr_b32 s4, s2, 6
  s_lshl_b32 s4, s4, 3
  s_and_b32 s6, s2, 7
  s_add_u32 s4, s4, s6
  s_mov_b32 s43, 0x20000
  s_mov_b32 s47, 0x20000
  s_mov_b32 s10, 0x40000000
  s_mov_b32 s11, 0x20000
  s_mul_i32 s12, s4, 12544
  s_cmp_ge_u32 s3, 4
  s_cbranch_scc1 L_KV
  s_setprio 3
  v_mov_b32 v4, 0
  v_mov_b32 v5, 0
  v_mov_b32 v6, 0
  s_and_b32 s7, s5, 1
  ds_write_b128 v1, v[4:7]
  ds_write_b128 v1, v[4:7] offset:1024
  s_and_b32 s13, s3, 1
  s_and_b32 s14, s5, 6
  s_add_u32 s14, s14, s13
  s_mul_i32 s14, s14, 80
  v_mul_u32_u24 v2, 20, v0
  v_lshrrev_b32 v3, 3, v0
  v_mul_u32_u24 v4, 20, v3
  v_and_b32 v5, 7, v0
  v_lshlrev_b32 v6, 4, v5
  s_lshl_b32 s48, s14, 1
  s_mov_b32 s46, 1280
  s_lshl_b32 s36, s4, 2
  s_lshr_b32 s36, 0x77727170, s36
  s_and_b32 s36, s36, 7
  s_add_u32 s36, s36, 24
  s_cmp_lt_u32 s4, 24
  s_cselect_b32 s36, s4, s36
  s_lshl_b32 s53, s36, 7
  s_lshl_b32 s54, s7, 7
  s_lshl_b32 s55, s4, 8
  s_add_u32 s54, s54, s55
  s_movk_i32 s52, 8192
  s_cmp_ge_u32 s3, 2
  s_cselect_b32 s52, 3456, s52
  s_cselect_b32 s53, s53, s54
  s_mul_i32 s42, s52, 640
  s_mul_i32 s49, s52, 10
  s_mov_b32 s51, s52
  s_mul_i32 s54, s14, s52
  s_add_u32 s53, s53, s54
  v_mad_u32_u24 v6, v3, s49, v6
  s_cmp_ge_u32 s36, 27
  s_cselect_b32 s15, 2, 4
  s_cmp_eq_u32 s7, 0
  s_waitcnt lgkmcnt(0)
  s_cselect_b32 s40, s28, s30
  s_cselect_b32 s41, s29, s31
  s_cmp_ge_u32 s3, 2
  s_cselect_b32 s40, s40, s22
  s_cselect_b32 s41, s41, s23
  s_mov_b32 s44, s16
  s_mov_b32 s45, s17
  s_cmp_ge_u32 s3, s15
  s_cbranch_scc1 L_Anoload
  buffer_load_dwordx4 v[24:27], v6, s[40:43], s53 offen nt
  s_add_u32 s53, s53, s51
  buffer_load_dwordx4 v[28:31], v6, s[40:43], s53 offen nt
  s_add_u32 s53, s53, s51
  buffer_load_dwordx4 v[32:35], v6, s[40:43], s53 offen nt
  s_add_u32 s53, s53, s51
  buffer_load_dwordx4 v[36:39], v6, s[40:43], s53 offen nt
  s_add_u32 s53, s53, s51
  buffer_load_dwordx4 v[40:43], v6, s[40:43], s53 offen nt
  s_add_u32 s53, s53, s51
  buffer_load_dwordx4 v[104:107], v2, s[44:47], 0 offen
  buffer_load_dword v108, v2, s[44:47], 0 offen offset:16
  buffer_load_dwordx4 v[110:113], v4, s[44:47], s48 offen
  buffer_load_dword v114, v4, s[44:47], s48 offen offset:16
  buffer_load_dwordx4 v[44:47], v6, s[40:43], s53 offen nt
  s_add_u32 s53, s53, s51
  buffer_load_dwordx4 v[48:51], v6, s[40:43], s53 offen nt
  s_add_u32 s53, s53, s51
  buffer_load_dwordx4 v[52:55], v6, s[40:43], s53 offen nt
  s_add_u32 s53, s53, s51
  buffer_load_dwordx4 v[56:59], v6, s[40:43], s53 offen nt
  s_add_u32 s53, s53, s51
  buffer_load_dwordx4 v[60:63], v6, s[40:43], s53 offen nt
L_Anoload:
  s_barrier
  s_load_dword s50, s[8:9], 0
  v_lshl_add_u32 v9, v5, 3, v3
  v_lshlrev_b32 v9, 3, v9
  v_lshlrev_b32 v8, 2, v0
  s_cmp_ge_u32 s3, s15
  s_cbranch_scc1 L_Adone
  s_mov_b32 s56, 0xffff0000
  s_mov_b32 s60, 0x05040100
  s_mov_b32 s61, 0x07060302
  s_lshl_b32 s49, s3, 8
  v_add_u32 v10, s49, v8
  v_mov_b32 v16, 0
  v_mov_b32 v17, 0
  v_mov_b32 v18, 0
  v_mov_b32 v19, 0
  v_mov_b32 v20, 0
  v_mov_b32 v21, 0
  v_mov_b32 v22, 0
  v_mov_b32 v23, 0
  s_waitcnt vmcnt(7)
  v_lshlrev_b32 v120, 16, v104
  v_and_b32 v121, s56, v104
  v_lshlrev_b32 v122, 16, v105
  v_and_b32 v123, s56, v105
  v_lshlrev_b32 v124, 16, v106
  v_and_b32 v125, s56, v106
  v_lshlrev_b32 v126, 16, v107
  v_and_b32 v127, s56, v107
  v_lshlrev_b32 v128, 16, v108
  v_and_b32 v129, s56, v108
  v_add_f32 v2, v120, v121
  v_add_f32 v2, v2, v122
  v_add_f32 v2, v2, v123
  v_add_f32 v2, v2, v124
  v_add_f32 v2, v2, v125
  v_add_f32 v2, v2, v126
  v_add_f32 v2, v2, v127
  v_add_f32 v2, v2, v128
  v_add_f32 v2, v2, v129
  s_nop 1
  v_add_f32_dpp v2, v2, v2 row_ror:8 row_mask:0xf bank_mask:0xf
  s_nop 1
  v_add_f32_dpp v2, v2, v2 row_ror:4 row_mask:0xf bank_mask:0xf
  s_nop 1
  v_add_f32_dpp v2, v2, v2 row_ror:2 row_mask:0xf bank_mask:0xf
  s_nop 1
  v_add_f32_dpp v2, v2, v2 row_ror:1 row_mask:0xf bank_mask:0xf
  v_mov_b32 v4, v2
  s_nop 1
  v_permlane16_swap_b32 v4, v2
  v_add_f32 v2, v4, v2
  v_mov_b32 v4, v2
  s_nop 1
  v_permlane32_swap_b32 v4, v2
  v_add_f32 v2, v4, v2
  v_mul_f32 v2, 0x3acccccd, v2
  v_sub_f32 v120, v120, v2
  v_sub_f32 v121, v121, v2
  v_sub_f32 v122, v122, v2
  v_sub_f32 v123, v123, v2
  v_sub_f32 v124, v124, v2
  v_sub_f32 v125, v125, v2
  v_sub_f32 v126, v126, v2
  v_sub_f32 v127, v127, v2
  v_sub_f32 v128, v128, v2
  v_sub_f32 v129, v129, v2
  v_mul_f32 v5, v120, v120
  v_fmac_f32 v5, v121, v121
  v_fmac_f32 v5, v122, v122
  v_fmac_f32 v5, v123, v123
  v_fmac_f32 v5, v124, v124
  v_fmac_f32 v5, v125, v125
  v_fmac_f32 v5, v126, v126
  v_fmac_f32 v5, v127, v127
  v_fmac_f32 v5, v128, v128
  v_fmac_f32 v5, v129, v129
  s_nop 1
  v_add_f32_dpp v5, v5, v5 row_ror:8 row_mask:0xf bank_mask:0xf
  s_nop 1
  v_add_f32_dpp v5, v5, v5 row_ror:4 row_mask:0xf bank_mask:0xf
  s_nop 1
  v_add_f32_dpp v5, v5, v5 row_ror:2 row_mask:0xf bank_mask:0xf
  s_nop 1
  v_add_f32_dpp v5, v5, v5 row_ror:1 row_mask:0xf bank_mask:0xf
  v_mov_b32 v4, v5
  s_nop 1
  v_permlane16_swap_b32 v4, v5
  v_add_f32 v5, v4, v5
  v_mov_b32 v4, v5
  s_nop 1
  v_permlane32_swap_b32 v4, v5
  v_add_f32 v5, v4, v5
  v_mul_f32 v5, 0x3acccccd, v5
  v_cvt_pk_bf16_f32 v2, 0, v2
  v_cvt_pk_bf16_f32 v5, 0, v5
  v_add_f32 v5, 0x3727c5ac, v5
  v_cvt_pk_bf16_f32 v5, 0, v5
  v_sqrt_f32 v5, v5
  s_nop 0
  v_cvt_pk_bf16_f32 v5, 0, v5
  v_rcp_f32 v5, v5
  s_waitcnt vmcnt(5)
  v_lshlrev_b32 v120, 16, v110
  v_and_b32 v121, s56, v110
  v_sub_f32 v120, v120, v2
  v_sub_f32 v121, v121, v2
  v_cvt_pk_bf16_f32 v120, 0, v120
  v_cvt_pk_bf16_f32 v121, 0, v121
  v_mul_f32 v120, v120, v5
  v_mul_f32 v121, v121, v5
  v_cvt_pk_bf16_f32 v130, v120, v121
  v_lshlrev_b32 v120, 16, v111
  v_and_b32 v121, s56, v111
  v_sub_f32 v120, v120, v2
  v_sub_f32 v121, v121, v2
  v_cvt_pk_bf16_f32 v120, 0, v120
  v_cvt_pk_bf16_f32 v121, 0, v121
  v_mul_f32 v120, v120, v5
  v_mul_f32 v121, v121, v5
  v_cvt_pk_bf16_f32 v131, v120, v121
  v_lshlrev_b32 v120, 16, v112
  v_and_b32 v121, s56, v112
  v_sub_f32 v120, v120, v2
  v_sub_f32 v121, v121, v2
  v_cvt_pk_bf16_f32 v120, 0, v120
  v_cvt_pk_bf16_f32 v121, 0, v121
  v_mul_f32 v120, v120, v5
  v_mul_f32 v121, v121, v5
  v_cvt_pk_bf16_f32 v132, v120, v121
  v_lshlrev_b32 v120, 16, v113
  v_and_b32 v121, s56, v113
  v_sub_f32 v120, v120, v2
  v_sub_f32 v121, v121, v2
  v_cvt_pk_bf16_f32 v120, 0, v120
  v_cvt_pk_bf16_f32 v121, 0, v121
  v_mul_f32 v120, v120, v5
  v_mul_f32 v121, v121, v5
  v_cvt_pk_bf16_f32 v133, v120, v121
  v_lshlrev_b32 v120, 16, v114
  v_and_b32 v121, s56, v114
  v_sub_f32 v120, v120, v2
  v_sub_f32 v121, v121, v2
  v_cvt_pk_bf16_f32 v120, 0, v120
  v_cvt_pk_bf16_f32 v121, 0, v121
  v_mul_f32 v120, v120, v5
  v_mul_f32 v121, v121, v5
  v_cvt_pk_bf16_f32 v134, v120, v121
  s_waitcnt vmcnt(8)
  v_perm_b32 v140, v28, v24, s61
  v_perm_b32 v24, v28, v24, s60
  v_perm_b32 v141, v29, v25, s61
  v_perm_b32 v25, v29, v25, s60
  v_perm_b32 v142, v30, v26, s61
  v_perm_b32 v26, v30, v26, s60
  v_perm_b32 v143, v31, v27, s61
  v_perm_b32 v27, v31, v27, s60
  v_dot2c_f32_bf16 v16, v24, v130
  v_dot2c_f32_bf16 v17, v140, v130
  v_dot2c_f32_bf16 v18, v25, v130
  v_dot2c_f32_bf16 v19, v141, v130
  v_dot2c_f32_bf16 v20, v26, v130
  v_dot2c_f32_bf16 v21, v142, v130
  v_dot2c_f32_bf16 v22, v27, v130
  v_dot2c_f32_bf16 v23, v143, v130
  s_waitcnt vmcnt(6)
  v_perm_b32 v140, v36, v32, s61
  v_perm_b32 v32, v36, v32, s60
  v_perm_b32 v141, v37, v33, s61
  v_perm_b32 v33, v37, v33, s60
  v_perm_b32 v142, v38, v34, s61
  v_perm_b32 v34, v38, v34, s60
  v_perm_b32 v143, v39, v35, s61
  v_perm_b32 v35, v39, v35, s60
  v_dot2c_f32_bf16 v16, v32, v131
  v_dot2c_f32_bf16 v17, v140, v131
  v_dot2c_f32_bf16 v18, v33, v131
  v_dot2c_f32_bf16 v19, v141, v131
  v_dot2c_f32_bf16 v20, v34, v131
  v_dot2c_f32_bf16 v21, v142, v131
  v_dot2c_f32_bf16 v22, v35, v131
  v_dot2c_f32_bf16 v23, v143, v131
  s_waitcnt vmcnt(4)
  v_perm_b32 v140, v44, v40, s61
  v_perm_b32 v40, v44, v40, s60
  v_perm_b32 v141, v45, v41, s61
  v_perm_b32 v41, v45, v41, s60
  v_perm_b32 v142, v46, v42, s61
  v_perm_b32 v42, v46, v42, s60
  v_perm_b32 v143, v47, v43, s61
  v_perm_b32 v43, v47, v43, s60
  v_dot2c_f32_bf16 v16, v40, v132
  v_dot2c_f32_bf16 v17, v140, v132
  v_dot2c_f32_bf16 v18, v41, v132
  v_dot2c_f32_bf16 v19, v141, v132
  v_dot2c_f32_bf16 v20, v42, v132
  v_dot2c_f32_bf16 v21, v142, v132
  v_dot2c_f32_bf16 v22, v43, v132
  v_dot2c_f32_bf16 v23, v143, v132
  s_waitcnt vmcnt(2)
  v_perm_b32 v140, v52, v48, s61
  v_perm_b32 v48, v52, v48, s60
  v_perm_b32 v141, v53, v49, s61
  v_perm_b32 v49, v53, v49, s60
  v_perm_b32 v142, v54, v50, s61
  v_perm_b32 v50, v54, v50, s60
  v_perm_b32 v143, v55, v51, s61
  v_perm_b32 v51, v55, v51, s60
  v_dot2c_f32_bf16 v16, v48, v133
  v_dot2c_f32_bf16 v17, v140, v133
  v_dot2c_f32_bf16 v18, v49, v133
  v_dot2c_f32_bf16 v19, v141, v133
  v_dot2c_f32_bf16 v20, v50, v133
  v_dot2c_f32_bf16 v21, v142, v133
  v_dot2c_f32_bf16 v22, v51, v133
  v_dot2c_f32_bf16 v23, v143, v133
  s_waitcnt vmcnt(0)
  v_perm_b32 v140, v60, v56, s61
  v_perm_b32 v56, v60, v56, s60
  v_perm_b32 v141, v61, v57, s61
  v_perm_b32 v57, v61, v57, s60
  v_perm_b32 v142, v62, v58, s61
  v_perm_b32 v58, v62, v58, s60
  v_perm_b32 v143, v63, v59, s61
  v_perm_b32 v59, v63, v59, s60
  v_dot2c_f32_bf16 v16, v56, v134
  v_dot2c_f32_bf16 v17, v140, v134
  v_dot2c_f32_bf16 v18, v57, v134
  v_dot2c_f32_bf16 v19, v141, v134
  v_dot2c_f32_bf16 v20, v58, v134
  v_dot2c_f32_bf16 v21, v142, v134
  v_dot2c_f32_bf16 v22, v59, v134
  v_dot2c_f32_bf16 v23, v143, v134
  v_permlane32_swap_b32 v16, v20
  v_permlane32_swap_b32 v17, v21
  v_permlane32_swap_b32 v18, v22
  v_permlane32_swap_b32 v19, v23
  v_add_f32 v16, v16, v20
  v_add_f32 v17, v17, v21
  v_add_f32 v18, v18, v22
  v_add_f32 v19, v19, v23
  s_nop 0
  v_permlane16_swap_b32 v16, v18
  v_permlane16_swap_b32 v17, v19
  v_add_f32 v16, v16, v18
  v_add_f32 v17, v17, v19
  s_nop 0
  v_add_f32_dpp v16, v16, v16 row_ror:8 row_mask:0xf bank_mask:0x3
  v_add_f32_dpp v16, v17, v17 row_ror:8 row_mask:0xf bank_mask:0xc
  ds_write_b32 v10, v16 offset:1024
L_Adone:
  v_mov_b32 v4, 1
  s_mov_b64 exec, 1
  ds_add_rtn_u32 v2, v7, v4 offset:20
  s_mov_b64 exec, -1
  ds_read2st64_b32 v[24:25], v8 offset0:4 offset1:6
  ds_read2st64_b32 v[26:27], v8 offset0:5 offset1:7
  s_lshl_b32 s49, s5, 9
  s_add_u32 s53, s12, 4096
  s_add_u32 s54, s53, s49
  s_mul_i32 s55, s5, 640
  s_add_u32 s55, s55, s12
  s_add_u32 s55, s55, 8192
  v_mov_b32 v44, -1
  v_mov_b32 v45, -1
  v_mov_b32 v46, -1
  v_mov_b32 v47, -1
  s_mov_b32 s62, -1
  s_movk_i32 s63, 0xff
  s_waitcnt lgkmcnt(0)
  v_readfirstlane_b32 s48, v2
  v_add_f32 v2, v24, v26
  v_add_f32 v3, v25, v27
  s_cmp_lg_u32 s48, 3
  s_cbranch_scc1 L_G
  buffer_store_dwordx2 v[2:3], v9, s[8:11], s54 offen
  s_mov_b64 exec, s[62:63]
  buffer_store_dwordx4 v[44:47], v1, s[8:11], s55 offen
  s_mov_b64 exec, -1
  s_getreg_b32 s56, hwreg(HW_REG_XCC_ID, 0, 4)
  s_mul_i32 s50, s50, 0x9e3779b1
  s_add_u32 s50, s50, 0x7f4a7c15
  s_mov_b32 s51, s50
  s_add_u32 s56, s56, s50
  s_mov_b32 s57, s56
  s_mov_b32 s6, s56
  s_add_u32 s52, s12, 13312
  s_lshl_b32 s49, s5, 2
  s_add_u32 s49, s49, s52
  s_mov_b32 s58, 2000000
  s_waitcnt vmcnt(0)
  s_atomic_swap s6, s[8:9], s49
L_A2p:
  s_sleep 8
  s_load_dwordx8 s[64:71], s[8:9], s52 glc
  s_sub_u32 s58, s58, 1
  s_cbranch_scc1 L_A2g
  s_waitcnt lgkmcnt(0)
  s_sub_u32 s48, s64, s50
  s_cmp_ge_u32 s48, 16
  s_cbranch_scc1 L_A2p
  s_sub_u32 s48, s65, s50
  s_cmp_ge_u32 s48, 16
  s_cbranch_scc1 L_A2p
  s_sub_u32 s48, s66, s50
  s_cmp_ge_u32 s48, 16
  s_cbranch_scc1 L_A2p
  s_sub_u32 s48, s67, s50
  s_cmp_ge_u32 s48, 16
  s_cbranch_scc1 L_A2p
  s_sub_u32 s48, s68, s50
  s_cmp_ge_u32 s48, 16
  s_cbranch_scc1 L_A2p
  s_sub_u32 s48, s69, s50
  s_cmp_ge_u32 s48, 16
  s_cbranch_scc1 L_A2p
  s_sub_u32 s48, s70, s50
  s_cmp_ge_u32 s48, 16
  s_cbranch_scc1 L_A2p
  s_sub_u32 s48, s71, s50
  s_cmp_ge_u32 s48, 16
  s_cbranch_scc1 L_A2p
  s_cmp_eq_u64 s[64:65], s[56:57]
  s_cbranch_scc0 L_Amix
  s_cmp_eq_u64 s[66:67], s[56:57]
  s_cbranch_scc0 L_Amix
  s_cmp_eq_u64 s[68:69], s[56:57]
  s_cbranch_scc0 L_Amix
  s_cmp_eq_u64 s[70:71], s[56:57]
  s_cbranch_scc0 L_Amix
L_A2g:
  buffer_load_dwordx4 v[24:27], v1, s[8:11], s53 offen offset:0 nt
  buffer_load_dwordx4 v[28:31], v1, s[8:11], s53 offen offset:1024 nt
  buffer_load_dwordx4 v[32:35], v1, s[8:11], s53 offen offset:2048 nt
  buffer_load_dwordx4 v[36:39], v1, s[8:11], s53 offen offset:3072 nt
L_A2s:
  s_waitcnt vmcnt(0) lgkmcnt(0)
  v_add_f32 v24, v24, v28
  v_add_f32 v32, v32, v36
  v_add_f32 v25, v25, v29
  v_add_f32 v33, v33, v37
  v_add_f32 v26, v26, v30
  v_add_f32 v34, v34, v38
  v_add_f32 v27, v27, v31
  v_add_f32 v35, v35, v39
  v_add_f32 v24, v24, v32
  v_add_f32 v25, v25, v33
  v_add_f32 v26, v26, v34
  v_add_f32 v27, v27, v35
  v_cvt_pk_bf16_f32 v28, v24, v26
  v_cvt_pk_bf16_f32 v25, 0, v25
  v_cvt_pk_bf16_f32 v27, 0, v27
  ds_write_b32 v8, v28 offset:256
  v_mov_b32 v29, v25
  v_mov_b32 v30, v27
  s_nop 0
  v_permlane32_swap_b32 v25, v29
  v_permlane32_swap_b32 v27, v30
  v_mul_f32 v32, 0xbfb8aa3b, v25
  v_mul_f32 v33, 0xbfb8aa3b, v27
  v_exp_f32 v32, v32
  v_exp_f32 v33, v33
  v_add_f32 v32, 1.0, v32
  v_add_f32 v33, 1.0, v33
  v_rcp_f32 v32, v32
  v_rcp_f32 v33, v33
  v_mul_f32 v32, v25, v32
  v_mul_f32 v33, v27, v33
  v_cvt_pk_bf16_f32 v32, 0, v32
  v_cvt_pk_bf16_f32 v33, 0, v33
  v_mul_f32 v32, v32, v29
  v_mul_f32 v33, v33, v30
  v_cvt_pk_bf16_f32 v28, v32, v33
  v_mov_b32 v3, s50
  ds_write_b32 v8, v28 offset:512
  s_mov_b64 exec, 1
  ds_write_b32 v7, v3 offset:12
  ds_write_b32 v7, v4 offset:0
  s_mov_b64 exec, -1
L_G:
  s_cmp_lg_u32 s3, 3
  s_cbranch_scc1 Lml_1
  v_and_b32 v113, 7, v0
  v_lshlrev_b32 v113, 3, v113
  s_mul_i32 s51, s5, 640
  s_add_u32 s51, s51, s12
  s_add_u32 s51, s51, 8192
  s_mov_b32 s58, 2000000
Lsp_2:
  ds_read_b32 v2, v7 offset:4
  s_waitcnt lgkmcnt(0)
  v_readfirstlane_b32 s48, v2
  s_nop 0
  s_cmp_ge_u32 s48, 8
  s_cbranch_scc1 Lspx_3
  s_sleep 2
  s_sub_u32 s58, s58, 1
  s_cbranch_scc0 Lsp_2
Lspx_3:
  ds_read_b64 v[110:111], v113 offset:64
  ds_read_b32 v114, v7 offset:0
  s_waitcnt lgkmcnt(0)
  v_mov_b32 v112, v110
  v_readfirstlane_b32 s7, v114
  s_nop 0
  v_max_f32_dpp v112, v112, v112 row_ror:4 row_mask:0xf bank_mask:0xf
  s_nop 1
  v_max_f32_dpp v112, v112, v112 row_ror:2 row_mask:0xf bank_mask:0xf
  s_nop 1
  v_max_f32_dpp v112, v112, v112 row_ror:1 row_mask:0xf bank_mask:0xf
  v_sub_f32 v110, v110, v112
  v_exp_f32 v110, v110
  s_nop 0
  v_mul_f32 v113, v110, v111
  s_nop 1
  v_add_f32_dpp v113, v113, v113 row_ror:4 row_mask:0xf bank_mask:0xf
  s_nop 1
  v_add_f32_dpp v113, v113, v113 row_ror:2 row_mask:0xf bank_mask:0xf
  s_nop 1
  v_add_f32_dpp v113, v113, v113 row_ror:1 row_mask:0xf bank_mask:0xf
  s_mov_b64 exec, 1
  s_cmp_eq_u32 s7, 1
  s_cbranch_scc0 Lms_4
  buffer_store_dwordx2 v[112:113], v7, s[8:11], s51 offen offset:512
  s_branch Lmx_5
Lms_4:
  buffer_store_dwordx2 v[112:113], v7, s[8:11], s51 offen offset:512 sc1
Lmx_5:
  s_mov_b64 exec, -1
Lml_1:
  v_lshrrev_b32 v3, 3, v0
  v_and_b32 v4, 7, v0
  v_lshlrev_b32 v5, 4, v4
  s_movk_i32 s49, 10240
  v_mad_u32_u24 v8, v3, s49, v5
  v_lshrrev_b32 v10, 4, v0
  v_lshl_add_u32 v10, v4, 2, v10
  v_lshlrev_b32 v10, 4, v10
  s_mov_b32 s76, -1
  s_mov_b32 s64, s8
  s_mov_b32 s65, s9
  s_mov_b32 s66, 990208
  s_mov_b32 s67, 0x20000
  s_mov_b32 s72, s34
  s_mov_b32 s73, s35
  s_mov_b32 s74, 1280
  s_mov_b32 s75, 0x20000
  s_mov_b32 s78, 3
  s_mov_b32 s79, 3
  v_lshrrev_b32 v104, 1, v0
  v_and_b32 v105, 1, v0
  v_mul_u32_u24 v104, 5120, v104
  v_lshl_add_u32 v104, v105, 4, v104
  v_lshrrev_b32 v2, 5, v0
  v_lshl_add_u32 v105, v105, 1, v2
  v_lshlrev_b32 v105, 1, v105
  s_cmp_ge_u32 s5, 5
  s_cbranch_scc1 L_Gd
  s_mov_b32 s40, s24
  s_mov_b32 s41, s25
  s_mov_b32 s42, 5242880
  s_lshr_b32 s14, s3, 1
  s_lshl_b32 s48, s4, 1
  s_add_u32 s48, s48, s14
  s_lshl_b32 s49, s5, 1
  s_add_u32 s49, s49, s13
  s_mul_i32 s52, s48, 81920
  s_mul_i32 s57, s4, 5120
  s_add_u32 s57, s57, 524288
  s_branch L_Gl
L_Gd:
  s_cmp_ge_u32 s36, 27
  s_cbranch_scc1 L_Gend
  s_sub_u32 s49, s5, 5
  s_lshl_b32 s49, s49, 2
  s_add_u32 s49, s49, s3
  s_cmp_ge_u32 s49, 10
  s_cbranch_scc1 L_Gend
  s_mov_b32 s40, s32
  s_mov_b32 s41, s33
  s_mov_b32 s42, 2211840
  s_mul_i32 s52, s36, 81920
  s_mul_i32 s57, s36, 5120
  s_add_u32 s57, s57, 851968
  s_cmp_ge_u32 s49, 8
  s_cbranch_scc1 L_Gl
  s_cmp_ge_u32 s4, 20
  s_cbranch_scc1 L_Gl
  s_lshl_b32 s76, s4, 3
  s_add_u32 s76, s76, s49
  s_lshl_b32 s48, s76, 5
  s_add_u32 s68, s48, 524288
  s_add_u32 s69, s48, 688128
  s_add_u32 s70, s48, 851968
  s_lshl_b32 s71, s76, 3
  buffer_load_ushort v106, v105, s[44:47], s71 offen
L_Gl:
  s_lshl_b32 s48, s49, 7
  s_add_u32 s52, s52, s48
  s_add_u32 s53, s52, 5120
  s_mul_i32 s48, s49, 512
  s_add_u32 s57, s57, s48
  s_mov_b32 s60, 0x05040100
  s_mov_b32 s61, 0x07060302
  s_mov_b32 s62, 0x00ff00ff
  s_mov_b32 s63, 0x00ff00ff
  s_add_u32 s54, s12, 8192
  s_lshl_b32 s55, s14, 8
  s_add_u32 s55, s55, s54
  v_lshrrev_b32 v2, 4, v0
  v_and_b32 v5, 15, v0
  v_mul_u32_u24 v11, 640, v2
  v_lshl_add_u32 v9, v5, 4, v11
  v_lshlrev_b32 v6, 4, v3
  s_lshl_b32 s48, s3, 7
  v_add_u32 v14, s48, v6
  v_lshl_add_u32 v15, v5, 2, v2
  v_lshlrev_b32 v15, 1, v15
  v_add_u32 v15, s48, v15
  v_mov_b32 v16, 0
  v_mov_b32 v17, 0
  v_mov_b32 v18, 0
  v_mov_b32 v19, 0
  v_mov_b32 v20, 0
  v_mov_b32 v21, 0
  v_mov_b32 v22, 0
  v_mov_b32 v23, 0
  v_lshlrev_b32 v116, 3, v0
  s_lshl_b32 s48, s3, 9
  s_add_u32 s48, s48, 2048
  s_xor_b32 s15, s48, 1024
  v_add_u32 v117, s15, v116
  v_add_u32 v116, s48, v116
  s_lshl_b32 s48, s13, 2
  v_mov_b32 v118, s48
  v_mov_b32 v119, 1
  s_mov_b32 s58, 2000000
Lsp_6:
  ds_read_b32 v2, v7 offset:24
  s_waitcnt lgkmcnt(0)
  v_readfirstlane_b32 s48, v2
  s_nop 0
  s_cmp_ge_u32 s48, 8
  s_cbranch_scc1 Lspx_7
  s_sleep 2
  s_sub_u32 s58, s58, 1
  s_cbranch_scc0 Lsp_6
Lspx_7:
  buffer_load_dwordx2 v[64:65], v11, s[8:11], s54 offen offset:512 sc1
  buffer_load_dwordx2 v[66:67], v11, s[8:11], s54 offen offset:3072 sc1
  buffer_load_dwordx4 v[24:27], v8, s[40:43], s52 offen offset:0 nt
  buffer_load_dwordx4 v[28:31], v8, s[40:43], s52 offen offset:1280 nt
  buffer_load_dwordx4 v[32:35], v8, s[40:43], s52 offen offset:2560 nt
  buffer_load_dwordx4 v[36:39], v8, s[40:43], s52 offen offset:3840 nt
  ds_read_b32 v77, v7 offset:12
  ds_read_b32 v79, v7 offset:12
  ds_read_b128 v[72:75], v6 offset:512
  buffer_load_dwordx4 v[40:43], v8, s[40:43], s53 offen offset:0 nt
  s_waitcnt vmcnt(4)
  buffer_load_dwordx4 v[44:47], v8, s[40:43], s53 offen offset:1280 nt
  s_waitcnt vmcnt(4)
  buffer_load_dwordx4 v[48:51], v8, s[40:43], s53 offen offset:2560 nt
  s_waitcnt vmcnt(4)
  buffer_load_dwordx4 v[52:55], v8, s[40:43], s53 offen offset:3840 nt
  s_waitcnt vmcnt(4) lgkmcnt(0)
  v_perm_b32 v88, v28, v24, s61
  v_perm_b32 v24, v28, v24, s60
  v_perm_b32 v89, v29, v25, s61
  v_perm_b32 v25, v29, v25, s60
  v_perm_b32 v90, v30, v26, s61
  v_perm_b32 v26, v30, v26, s60
  v_perm_b32 v91, v31, v27, s61
  v_perm_b32 v27, v31, v27, s60
  v_perm_b32 v92, v36, v32, s61
  v_perm_b32 v32, v36, v32, s60
  v_perm_b32 v93, v37, v33, s61
  v_perm_b32 v33, v37, v33, s60
  v_perm_b32 v94, v38, v34, s61
  v_perm_b32 v34, v38, v34, s60
  v_perm_b32 v95, v39, v35, s61
  v_perm_b32 v35, v39, v35, s60
  s_mov_b32 s58, 2000000
  s_cmp_lt_u32 s5, 5
  s_cbranch_scc1 L_Gmc
  v_cmp_gt_u32 vcc, 54, v0
  v_lshlrev_b32 v106, 16, v106
  s_nop 0
  v_cndmask_b32 v107, 0, v77, vcc
  s_waitcnt vmcnt(0)
  s_branch L_Gw
L_Gmr:
  buffer_load_dwordx2 v[64:65], v11, s[8:11], s54 offen offset:512 sc1
  buffer_load_dwordx2 v[66:67], v11, s[8:11], s54 offen offset:3072 sc1
  s_waitcnt vmcnt(0)
L_Gmc:
  s_sub_u32 s58, s58, 1
  s_cbranch_scc1 L_Gmx
  v_max3_u32 v2, v64, v65, v66
  v_max_u32 v2, v2, v67
  v_cmp_eq_u32 vcc, -1, v2
  s_nop 0
  s_cbranch_vccnz L_Gmr
L_Gmx:
  v_max_f32 v2, v64, v66
  v_mov_b32 v3, v2
  s_nop 1
  v_permlane16_swap_b32 v3, v2
  v_max_f32 v2, v3, v2
  v_mov_b32 v3, v2
  s_nop 1
  v_permlane32_swap_b32 v3, v2
  v_max_f32 v2, v3, v2
  v_sub_f32 v12, v64, v2
  v_sub_f32 v13, v66, v2
  v_exp_f32 v12, v12
  v_exp_f32 v13, v13
  v_mul_f32 v2, v12, v65
  v_fmac_f32 v2, v13, v67
  v_mov_b32 v3, v2
  s_nop 1
  v_permlane16_swap_b32 v3, v2
  v_add_f32 v2, v3, v2
  v_mov_b32 v3, v2
  s_nop 1
  v_permlane32_swap_b32 v3, v2
  v_add_f32 v2, v3, v2
  v_rcp_f32 v2, v2
  s_nop 0
  v_mul_f32 v12, v12, v2
  v_mul_f32 v13, v13, v2
  s_mov_b32 s58, 2000000
Lsp_8:
  ds_read_b32 v2, v7 offset:16
  s_waitcnt lgkmcnt(0)
  v_readfirstlane_b32 s48, v2
  s_nop 0
  s_cmp_ge_u32 s48, 1
  s_cbranch_scc1 Lspx_9
  s_sub_u32 s58, s58, 1
  s_cbranch_scc0 Lsp_8
Lspx_9:
  buffer_load_dwordx4 v[56:59], v9, s[8:11], s55 offen offset:0 sc1
  buffer_load_dwordx4 v[60:63], v9, s[8:11], s55 offen offset:2560 sc1
  s_mov_b32 s58, 2000000
  s_waitcnt vmcnt(2)
L_Gw:
  v_perm_b32 v96, v44, v40, s61
  v_perm_b32 v40, v44, v40, s60
  v_perm_b32 v97, v45, v41, s61
  v_perm_b32 v41, v45, v41, s60
  v_perm_b32 v98, v46, v42, s61
  v_perm_b32 v42, v46, v42, s60
  v_perm_b32 v99, v47, v43, s61
  v_perm_b32 v43, v47, v43, s60
  v_perm_b32 v100, v52, v48, s61
  v_perm_b32 v48, v52, v48, s60
  v_perm_b32 v101, v53, v49, s61
  v_perm_b32 v49, v53, v49, s60
  v_perm_b32 v102, v54, v50, s61
  v_perm_b32 v50, v54, v50, s60
  v_perm_b32 v103, v55, v51, s61
  v_perm_b32 v51, v55, v51, s60
  s_cmp_ge_u32 s5, 5
  s_cbranch_scc1 L_Gdot
  s_branch L_Gchk
L_Gre:
  buffer_load_dwordx4 v[56:59], v9, s[8:11], s55 offen offset:0 sc1
  buffer_load_dwordx4 v[60:63], v9, s[8:11], s55 offen offset:2560 sc1
L_Gchk:
  s_sub_u32 s58, s58, 1
  s_waitcnt vmcnt(0)
  s_cbranch_scc1 L_Gc
  v_max3_u32 v2, v56, v57, v58
  v_max3_u32 v3, v59, v60, v61
  v_max3_u32 v2, v2, v62, v63
  v_max_u32 v2, v2, v3
  v_cmp_eq_u32 vcc, -1, v2
  s_nop 0
  s_and_b64 exec, exec, vcc
  s_cbranch_execnz L_Gre
L_Gc:
  s_mov_b64 exec, -1
  v_mul_f32 v56, v12, v56
  v_mul_f32 v57, v12, v57
  v_mul_f32 v58, v12, v58
  v_mul_f32 v59, v12, v59
  v_fmac_f32 v56, v13, v60
  v_fmac_f32 v57, v13, v61
  v_fmac_f32 v58, v13, v62
  v_fmac_f32 v59, v13, v63
  s_nop 0
  v_permlane32_swap_b32 v56, v58
  v_permlane32_swap_b32 v57, v59
  v_add_f32 v56, v56, v58
  v_add_f32 v57, v57, v59
  s_nop 1
  v_permlane16_swap_b32 v56, v57
  v_add_f32 v56, v56, v57
  v_cvt_pk_bf16_f32 v56, v56, v56
  ds_write_b16 v15, v56 offset:1024
  ds_read_b128 v[72:75], v14 offset:1024
  s_waitcnt lgkmcnt(0)
L_Gdot:
  v_dot2c_f32_bf16 v16, v24, v72
  v_dot2c_f32_bf16 v17, v88, v72
  v_dot2c_f32_bf16 v18, v25, v72
  v_dot2c_f32_bf16 v19, v89, v72
  v_dot2c_f32_bf16 v20, v26, v72
  v_dot2c_f32_bf16 v21, v90, v72
  v_dot2c_f32_bf16 v22, v27, v72
  v_dot2c_f32_bf16 v23, v91, v72
  v_dot2c_f32_bf16 v16, v32, v73
  v_dot2c_f32_bf16 v17, v92, v73
  v_dot2c_f32_bf16 v18, v33, v73
  v_dot2c_f32_bf16 v19, v93, v73
  v_dot2c_f32_bf16 v20, v34, v73
  v_dot2c_f32_bf16 v21, v94, v73
  v_dot2c_f32_bf16 v22, v35, v73
  v_dot2c_f32_bf16 v23, v95, v73
  v_dot2c_f32_bf16 v16, v40, v74
  v_dot2c_f32_bf16 v17, v96, v74
  v_dot2c_f32_bf16 v18, v41, v74
  v_dot2c_f32_bf16 v19, v97, v74
  v_dot2c_f32_bf16 v20, v42, v74
  v_dot2c_f32_bf16 v21, v98, v74
  v_dot2c_f32_bf16 v22, v43, v74
  v_dot2c_f32_bf16 v23, v99, v74
  v_dot2c_f32_bf16 v16, v48, v75
  v_dot2c_f32_bf16 v17, v100, v75
  v_dot2c_f32_bf16 v18, v49, v75
  v_dot2c_f32_bf16 v19, v101, v75
  v_dot2c_f32_bf16 v20, v50, v75
  v_dot2c_f32_bf16 v21, v102, v75
  v_dot2c_f32_bf16 v22, v51, v75
  v_dot2c_f32_bf16 v23, v103, v75
  v_permlane32_swap_b32 v16, v20
  v_permlane32_swap_b32 v17, v21
  v_permlane32_swap_b32 v18, v22
  v_permlane32_swap_b32 v19, v23
  v_add_f32 v16, v16, v20
  v_add_f32 v17, v17, v21
  v_add_f32 v18, v18, v22
  v_add_f32 v19, v19, v23
  s_nop 0
  v_permlane16_swap_b32 v16, v18
  v_permlane16_swap_b32 v17, v19
  v_add_f32 v16, v16, v18
  v_add_f32 v17, v17, v19
  s_nop 0
  v_add_f32_dpp v76, v16, v16 row_ror:8 row_mask:0xf bank_mask:0xf
  v_add_f32_dpp v78, v17, v17 row_ror:8 row_mask:0xf bank_mask:0xf
  s_cmp_ge_u32 s5, 5
  s_cbranch_scc1 L_Gst
  ds_write2_b32 v116, v76, v78 offset0:0 offset1:1
  s_mov_b64 exec, 1
  ds_add_rtn_u32 v2, v118, v119 offset:40
  s_mov_b64 exec, -1
  ds_read_b64 v[4:5], v117
  s_waitcnt lgkmcnt(0)
  v_readfirstlane_b32 s48, v2
  v_add_f32 v76, v76, v4
  v_add_f32 v78, v78, v5
  s_cmp_eq_u32 s48, 0
  s_cbranch_scc1 L_Gend
L_Gst:
  s_mov_b64 exec, s[62:63]
  buffer_store_dwordx4 v[76:79], v10, s[8:11], s57 offen sc1
  s_cmp_eq_u32 s76, -1
  s_cbranch_scc1 L_Gend
  s_mov_b64 exec, -1
  s_mov_b32 s58, 2000000
L_ry:
  buffer_load_dwordx4 v[24:27], v104, s[64:67], s68 offen sc1
  buffer_load_dwordx4 v[32:35], v104, s[64:67], s70 offen sc1
  s_sub_u32 s58, s58, 1
  s_waitcnt vmcnt(0)
  s_cbranch_scc1 L_ryx
  v_xor_b32 v2, v25, v77
  v_xor_b32 v3, v33, v107
  v_bitop3_b32 v2, v27, v77, v2 bitop3:0xbe
  v_bitop3_b32 v3, v35, v107, v3 bitop3:0xbe
  v_or_b32 v2, v2, v3
  v_cmp_ne_u32 vcc, 0, v2
  s_nop 0
  s_and_b64 exec, exec, vcc
  s_cbranch_execnz L_ry
L_ryx:
  s_mov_b64 exec, -1
  v_permlane32_swap_b32 v32, v34
  v_add_f32 v32, v32, v34
  v_mov_b32 v33, v32
  v_permlane32_swap_b32 v24, v26
  v_add_f32 v24, v24, v26
  v_permlane16_swap_b32 v32, v33
  v_mov_b32 v25, v24
  v_add_f32 v32, v32, v33
  s_nop 0
  v_permlane16_swap_b32 v24, v25
  v_add_f32_dpp v32, v32, v32 row_ror:8 row_mask:0xf bank_mask:0xf
  v_add_f32 v24, v24, v25
  s_nop 0
  v_add_f32_dpp v32, v32, v32 row_ror:4 row_mask:0xf bank_mask:0xf
  v_add_f32_dpp v24, v24, v24 row_ror:8 row_mask:0xf bank_mask:0xf
  s_nop 0
  v_add_f32_dpp v32, v32, v32 row_ror:2 row_mask:0xf bank_mask:0xf
  v_add_f32_dpp v24, v24, v24 row_ror:4 row_mask:0xf bank_mask:0xf
  v_cvt_pk_bf16_f32 v32, 0, v32
  v_mul_f32 v2, 0xbfb8aa3b, v32
  v_add_f32_dpp v24, v24, v24 row_ror:2 row_mask:0xf bank_mask:0xf
  v_exp_f32 v2, v2
  v_cvt_pk_bf16_f32 v24, 0, v24
  v_add_f32 v2, 1.0, v2
  v_rcp_f32 v2, v2
  s_mov_b64 exec, s[78:79]
  v_mul_f32 v2, v32, v2
  v_cvt_pk_bf16_f32 v2, 0, v2
  v_mul_f32 v2, v24, v2
  v_cvt_pk_bf16_f32 v2, 0, v2
  v_add_f32 v2, v106, v2
  v_cvt_pk_bf16_f32 v2, v2, v2
  buffer_store_short v2, v105, s[72:75], s71 offen
  s_cmp_lg_u32 s76, 0
  s_cbranch_scc1 L_rnb
  s_mov_b64 exec, 1
  buffer_store_dword v77, v7, s[8:11], 0 offen sc1
L_rnb:
L_Gend:
L_end:
  s_endpgm
L_Amix:
  buffer_store_dwordx2 v[2:3], v9, s[8:11], s54 offen sc1
  s_mov_b64 exec, s[62:63]
  buffer_store_dwordx4 v[44:47], v1, s[8:11], s55 offen sc1
  s_mov_b64 exec, -1
  s_mov_b32 s6, s50
  s_mov_b32 s58, 2000000
  v_mov_b32 v4, 2
  s_waitcnt vmcnt(0)
  s_atomic_swap s6, s[8:9], s49 offset:32
L_Amp:
  s_sleep 8
  s_load_dwordx8 s[64:71], s[8:9], s52 offset:32 glc
  s_sub_u32 s58, s58, 1
  s_cbranch_scc1 L_Amg
  s_waitcnt lgkmcnt(0)
  s_cmp_eq_u64 s[64:65], s[50:51]
  s_cbranch_scc0 L_Amp
  s_cmp_eq_u64 s[66:67], s[50:51]
  s_cbranch_scc0 L_Amp
  s_cmp_eq_u64 s[68:69], s[50:51]
  s_cbranch_scc0 L_Amp
  s_cmp_eq_u64 s[70:71], s[50:51]
  s_cbranch_scc0 L_Amp
L_Amg:
  buffer_load_dwordx4 v[24:27], v1, s[8:11], s53 offen offset:0 sc1
  buffer_load_dwordx4 v[28:31], v1, s[8:11], s53 offen offset:1024 sc1
  buffer_load_dwordx4 v[32:35], v1, s[8:11], s53 offen offset:2048 sc1
  buffer_load_dwordx4 v[36:39], v1, s[8:11], s53 offen offset:3072 sc1
  s_branch L_A2s
.p2align 6
L_KV:
  s_setprio 1
  s_mov_b32 s42, 0x100000
  s_mov_b32 s46, 0x100000
  s_lshl_b32 s48, s4, 23
  s_add_u32 s48, s48, 7340032
  s_sub_u32 s6, s3, 4
  s_mul_i32 s49, s4, 4
  s_lshl_b32 s50, s5, 3
  s_add_u32 s49, s49, s50
  s_add_u32 s49, s49, s6
  s_mul_i32 s52, s49, 4096
  s_and_b32 s52, s52, 1048575
  s_mov_b32 s60, 0xcccccccc
  s_mov_b32 s61, 0xcccccccc
  s_mov_b32 s62, 0xaaaaaaaa
  s_mov_b32 s63, 0xaaaaaaaa
  v_and_b32 v3, 15, v0
  v_lshrrev_b32 v4, 4, v0
  v_lshlrev_b32 v5, 5, v3
  v_lshl_or_b32 v6, v4, 3, v5
  v_lshlrev_b32 v3, 4, v3
  s_mul_i32 s51, s5, 640
  s_add_u32 s51, s51, s12
  s_add_u32 s51, s51, 8192
  v_mov_b32 v16, 0
  v_mov_b32 v17, 0
  v_mov_b32 v18, 0
  v_mov_b32 v19, 0
  v_mov_b32 v20, 0
  v_mov_b32 v21, 0
  v_mov_b32 v22, 0
  v_mov_b32 v23, 0
  s_waitcnt lgkmcnt(0)
  s_add_u32 s40, s18, s48
  s_addc_u32 s41, s19, 0
  s_add_u32 s44, s20, s48
  s_addc_u32 s45, s21, 0
  s_barrier
  buffer_load_dwordx4 v[24:27], v1, s[40:43], s52 offen offset:0 nt
  buffer_load_dwordx4 v[28:31], v1, s[40:43], s52 offen offset:1024 nt
  buffer_load_dwordx4 v[32:35], v1, s[40:43], s52 offen offset:2048 nt
  buffer_load_dwordx4 v[36:39], v1, s[40:43], s52 offen offset:3072 nt
  s_add_u32 s52, s52, 262144
  s_and_b32 s52, s52, 1048575
  s_waitcnt vmcnt(3)
  buffer_load_dwordx4 v[40:43], v1, s[40:43], s52 offen offset:0 nt
  s_waitcnt vmcnt(3)
  buffer_load_dwordx4 v[44:47], v1, s[40:43], s52 offen offset:1024 nt
  s_waitcnt vmcnt(3)
  buffer_load_dwordx4 v[48:51], v1, s[40:43], s52 offen offset:2048 nt
  s_waitcnt vmcnt(3)
  buffer_load_dwordx4 v[52:55], v1, s[40:43], s52 offen offset:3072 nt
  s_add_u32 s52, s52, 262144
  s_and_b32 s52, s52, 1048575
  s_waitcnt vmcnt(3)
  buffer_load_dwordx4 v[56:59], v1, s[40:43], s52 offen offset:0 nt
  s_waitcnt vmcnt(3)
  buffer_load_dwordx4 v[60:63], v1, s[40:43], s52 offen offset:1024 nt
  s_waitcnt vmcnt(3)
  buffer_load_dwordx4 v[64:67], v1, s[40:43], s52 offen offset:2048 nt
  s_waitcnt vmcnt(3)
  buffer_load_dwordx4 v[68:71], v1, s[40:43], s52 offen offset:3072 nt
  s_add_u32 s52, s52, 262144
  s_and_b32 s52, s52, 1048575
  s_waitcnt vmcnt(3)
  buffer_load_dwordx4 v[72:75], v1, s[40:43], s52 offen offset:0 nt
  s_waitcnt vmcnt(3)
  buffer_load_dwordx4 v[76:79], v1, s[40:43], s52 offen offset:1024 nt
  s_waitcnt vmcnt(3)
  buffer_load_dwordx4 v[80:83], v1, s[40:43], s52 offen offset:2048 nt
  s_waitcnt vmcnt(3)
  buffer_load_dwordx4 v[84:87], v1, s[40:43], s52 offen offset:3072 nt
  s_add_u32 s52, s52, 262144
  s_and_b32 s52, s52, 1048575
  s_waitcnt vmcnt(3)
  buffer_load_dwordx4 v[88:91], v1, s[44:47], s52 offen offset:0 nt
  s_waitcnt vmcnt(3)
  buffer_load_dwordx4 v[92:95], v1, s[44:47], s52 offen offset:1024 nt
  s_waitcnt vmcnt(3)
  buffer_load_dwordx4 v[96:99], v1, s[44:47], s52 offen offset:2048 nt
  s_waitcnt vmcnt(3)
  buffer_load_dwordx4 v[100:103], v1, s[44:47], s52 offen offset:3072 nt
  s_add_u32 s52, s52, 262144
  s_and_b32 s52, s52, 1048575
  s_waitcnt vmcnt(3)
  buffer_load_dwordx4 v[104:107], v1, s[44:47], s52 offen offset:0 nt
  s_waitcnt vmcnt(3)
  buffer_load_dwordx4 v[108:111], v1, s[44:47], s52 offen offset:1024 nt
  s_waitcnt vmcnt(3)
  buffer_load_dwordx4 v[112:115], v1, s[44:47], s52 offen offset:2048 nt
  s_waitcnt vmcnt(3)
  buffer_load_dwordx4 v[116:119], v1, s[44:47], s52 offen offset:3072 nt
  s_add_u32 s52, s52, 262144
  s_and_b32 s52, s52, 1048575
  s_mov_b32 s58, 2000000
Lsp_10:
  ds_read_b32 v2, v7 offset:0
  s_waitcnt lgkmcnt(0)
  v_readfirstlane_b32 s48, v2
  s_nop 0
  s_cmp_ge_u32 s48, 1
  s_cbranch_scc1 Lspx_11
  s_sleep 1
  s_sub_u32 s58, s58, 1
  s_cbranch_scc0 Lsp_10
Lspx_11:
  s_mov_b32 s7, s48
  ds_read_b128 v[8:11], v3 offset:256
  s_waitcnt lgkmcnt(0)
  v_dot2_f32_bf16 v24, v24, v8, 0
  v_dot2_f32_bf16 v28, v28, v8, 0
  v_dot2_f32_bf16 v32, v32, v8, 0
  v_dot2_f32_bf16 v36, v36, v8, 0
  v_dot2_f32_bf16 v40, v40, v8, 0
  v_dot2_f32_bf16 v44, v44, v8, 0
  v_dot2_f32_bf16 v48, v48, v8, 0
  v_dot2_f32_bf16 v52, v52, v8, 0
  v_dot2_f32_bf16 v56, v56, v8, 0
  v_dot2_f32_bf16 v60, v60, v8, 0
  v_dot2_f32_bf16 v64, v64, v8, 0
  v_dot2_f32_bf16 v68, v68, v8, 0
  v_dot2_f32_bf16 v72, v72, v8, 0
  v_dot2_f32_bf16 v76, v76, v8, 0
  v_dot2_f32_bf16 v80, v80, v8, 0
  v_dot2_f32_bf16 v84, v84, v8, 0
  v_dot2c_f32_bf16 v24, v25, v9
  v_dot2c_f32_bf16 v28, v29, v9
  v_dot2c_f32_bf16 v32, v33, v9
  v_dot2c_f32_bf16 v36, v37, v9
  v_dot2c_f32_bf16 v40, v41, v9
  v_dot2c_f32_bf16 v44, v45, v9
  v_dot2c_f32_bf16 v48, v49, v9
  v_dot2c_f32_bf16 v52, v53, v9
  v_dot2c_f32_bf16 v56, v57, v9
  v_dot2c_f32_bf16 v60, v61, v9
  v_dot2c_f32_bf16 v64, v65, v9
  v_dot2c_f32_bf16 v68, v69, v9
  v_dot2c_f32_bf16 v72, v73, v9
  v_dot2c_f32_bf16 v76, v77, v9
  v_dot2c_f32_bf16 v80, v81, v9
  v_dot2c_f32_bf16 v84, v85, v9
  s_waitcnt vmcnt(3)
  buffer_load_dwordx4 v[120:123], v1, s[44:47], s52 offen offset:0 nt
  v_dot2c_f32_bf16 v24, v26, v10
  v_dot2c_f32_bf16 v28, v30, v10
  v_dot2c_f32_bf16 v32, v34, v10
  v_dot2c_f32_bf16 v36, v38, v10
  v_dot2c_f32_bf16 v40, v42, v10
  v_dot2c_f32_bf16 v44, v46, v10
  v_dot2c_f32_bf16 v48, v50, v10
  v_dot2c_f32_bf16 v52, v54, v10
  v_dot2c_f32_bf16 v56, v58, v10
  v_dot2c_f32_bf16 v60, v62, v10
  v_dot2c_f32_bf16 v64, v66, v10
  v_dot2c_f32_bf16 v68, v70, v10
  v_dot2c_f32_bf16 v72, v74, v10
  v_dot2c_f32_bf16 v76, v78, v10
  v_dot2c_f32_bf16 v80, v82, v10
  v_dot2c_f32_bf16 v84, v86, v10
  v_dot2c_f32_bf16 v24, v27, v11
  v_dot2c_f32_bf16 v28, v31, v11
  v_dot2c_f32_bf16 v32, v35, v11
  v_dot2c_f32_bf16 v36, v39, v11
  v_dot2c_f32_bf16 v40, v43, v11
  v_dot2c_f32_bf16 v44, v47, v11
  v_dot2c_f32_bf16 v48, v51, v11
  v_dot2c_f32_bf16 v52, v55, v11
  v_dot2c_f32_bf16 v56, v59, v11
  v_dot2c_f32_bf16 v60, v63, v11
  v_dot2c_f32_bf16 v64, v67, v11
  v_dot2c_f32_bf16 v68, v71, v11
  v_dot2c_f32_bf16 v72, v75, v11
  v_dot2c_f32_bf16 v76, v79, v11
  v_dot2c_f32_bf16 v80, v83, v11
  v_dot2c_f32_bf16 v84, v87, v11
  s_waitcnt vmcnt(3)
  buffer_load_dwordx4 v[124:127], v1, s[44:47], s52 offen offset:1024 nt
  v_add_f32_dpp v24, v24, v24 row_ror:8 row_mask:0xf bank_mask:0x3
  v_add_f32_dpp v28, v28, v28 row_ror:8 row_mask:0xf bank_mask:0x3
  v_add_f32_dpp v32, v32, v32 row_ror:8 row_mask:0xf bank_mask:0x3
  v_add_f32_dpp v36, v36, v36 row_ror:8 row_mask:0xf bank_mask:0x3
  v_add_f32_dpp v40, v40, v40 row_ror:8 row_mask:0xf bank_mask:0x3
  v_add_f32_dpp v44, v44, v44 row_ror:8 row_mask:0xf bank_mask:0x3
  v_add_f32_dpp v48, v48, v48 row_ror:8 row_mask:0xf bank_mask:0x3
  v_add_f32_dpp v52, v52, v52 row_ror:8 row_mask:0xf bank_mask:0x3
  v_add_f32_dpp v24, v56, v56 row_ror:8 row_mask:0xf bank_mask:0xc
  v_add_f32_dpp v28, v60, v60 row_ror:8 row_mask:0xf bank_mask:0xc
  v_add_f32_dpp v32, v64, v64 row_ror:8 row_mask:0xf bank_mask:0xc
  v_add_f32_dpp v36, v68, v68 row_ror:8 row_mask:0xf bank_mask:0xc
  v_add_f32_dpp v40, v72, v72 row_ror:8 row_mask:0xf bank_mask:0xc
  v_add_f32_dpp v44, v76, v76 row_ror:8 row_mask:0xf bank_mask:0xc
  v_add_f32_dpp v48, v80, v80 row_ror:8 row_mask:0xf bank_mask:0xc
  v_add_f32_dpp v52, v84, v84 row_ror:8 row_mask:0xf bank_mask:0xc
  v_add_f32_dpp v24, v24, v24 row_shl:4 row_mask:0xf bank_mask:0x5
  v_add_f32_dpp v28, v28, v28 row_shl:4 row_mask:0xf bank_mask:0x5
  v_add_f32_dpp v32, v32, v32 row_shl:4 row_mask:0xf bank_mask:0x5
  v_add_f32_dpp v36, v36, v36 row_shl:4 row_mask:0xf bank_mask:0x5
  v_add_f32_dpp v24, v40, v40 row_shr:4 row_mask:0xf bank_mask:0xa
  v_add_f32_dpp v28, v44, v44 row_shr:4 row_mask:0xf bank_mask:0xa
  v_add_f32_dpp v32, v48, v48 row_shr:4 row_mask:0xf bank_mask:0xa
  v_add_f32_dpp v36, v52, v52 row_shr:4 row_mask:0xf bank_mask:0xa
  v_add_f32_dpp v24, v24, v24 quad_perm:[2,3,0,1] row_mask:0xf bank_mask:0xf
  v_add_f32_dpp v28, v28, v28 quad_perm:[2,3,0,1] row_mask:0xf bank_mask:0xf
  v_add_f32_dpp v32, v32, v32 quad_perm:[2,3,0,1] row_mask:0xf bank_mask:0xf
  v_add_f32_dpp v36, v36, v36 quad_perm:[2,3,0,1] row_mask:0xf bank_mask:0xf
  v_cndmask_b32 v24, v24, v32, s[60:61]
  v_cndmask_b32 v28, v28, v36, s[60:61]
  s_nop 0
  v_add_f32_dpp v24, v24, v24 quad_perm:[1,0,3,2] row_mask:0xf bank_mask:0xf
  v_add_f32_dpp v28, v28, v28 quad_perm:[1,0,3,2] row_mask:0xf bank_mask:0xf
  v_cndmask_b32 v2, v24, v28, s[62:63]
  v_cvt_pk_bf16_f32 v2, 0, v2
  v_mul_f32 v2, 0x3db504f3, v2
  v_cvt_pk_bf16_f32 v2, 0, v2
  v_mul_f32 v2, 0x3fb8aa3b, v2
  v_mov_b32 v14, v2
  s_waitcnt vmcnt(3)
  buffer_load_dwordx4 v[128:131], v1, s[44:47], s52 offen offset:2048 nt
  v_max_f32_dpp v14, v14, v14 row_ror:8 row_mask:0xf bank_mask:0xf
  s_nop 1
  v_max_f32_dpp v14, v14, v14 row_ror:4 row_mask:0xf bank_mask:0xf
  s_nop 1
  v_max_f32_dpp v14, v14, v14 row_ror:2 row_mask:0xf bank_mask:0xf
  s_nop 1
  v_max_f32_dpp v14, v14, v14 row_ror:1 row_mask:0xf bank_mask:0xf
  v_mov_b32 v3, v14
  s_nop 1
  v_permlane16_swap_b32 v3, v14
  v_max_f32 v14, v3, v14
  v_mov_b32 v3, v14
  s_nop 1
  v_permlane32_swap_b32 v3, v14
  v_max_f32 v14, v3, v14
  v_sub_f32 v2, v2, v14
  v_exp_f32 v2, v2
  s_lshl_b32 s48, s6, 3
  v_mov_b32 v4, s48
  v_mov_b32 v15, v2
  v_cvt_pk_bf16_f32 v12, v2, 0
  v_cvt_pk_bf16_f32 v13, 0, v2
  v_add_f32_dpp v15, v15, v15 row_ror:8 row_mask:0xf bank_mask:0xf
  s_nop 1
  v_add_f32_dpp v15, v15, v15 row_ror:4 row_mask:0xf bank_mask:0xf
  s_nop 1
  v_add_f32_dpp v15, v15, v15 row_ror:2 row_mask:0xf bank_mask:0xf
  s_nop 1
  v_add_f32_dpp v15, v15, v15 row_ror:1 row_mask:0xf bank_mask:0xf
  v_mov_b32 v3, v15
  s_nop 1
  v_permlane16_swap_b32 v3, v15
  v_add_f32 v15, v3, v15
  v_mov_b32 v3, v15
  s_nop 1
  v_permlane32_swap_b32 v3, v15
  v_add_f32 v15, v3, v15
  v_mov_b32 v9, 1
  s_mov_b64 exec, 1
  ds_write_b64 v4, v[14:15] offset:64
  ds_add_u32 v7, v9 offset:4
  s_mov_b64 exec, -1
  s_waitcnt vmcnt(3)
  buffer_load_dwordx4 v[132:135], v1, s[44:47], s52 offen offset:3072 nt
  s_add_u32 s52, s52, 262144
  s_and_b32 s52, s52, 1048575
  v_dot2c_f32_bf16_dpp v16, v12, v88 row_newbcast:0 row_mask:0xf bank_mask:0xf
  v_dot2c_f32_bf16_dpp v17, v13, v88 row_newbcast:0 row_mask:0xf bank_mask:0xf
  v_dot2c_f32_bf16_dpp v18, v12, v89 row_newbcast:0 row_mask:0xf bank_mask:0xf
  v_dot2c_f32_bf16_dpp v19, v13, v89 row_newbcast:0 row_mask:0xf bank_mask:0xf
  v_dot2c_f32_bf16_dpp v20, v12, v90 row_newbcast:0 row_mask:0xf bank_mask:0xf
  v_dot2c_f32_bf16_dpp v21, v13, v90 row_newbcast:0 row_mask:0xf bank_mask:0xf
  v_dot2c_f32_bf16_dpp v22, v12, v91 row_newbcast:0 row_mask:0xf bank_mask:0xf
  v_dot2c_f32_bf16_dpp v23, v13, v91 row_newbcast:0 row_mask:0xf bank_mask:0xf
  v_dot2c_f32_bf16_dpp v16, v12, v92 row_newbcast:1 row_mask:0xf bank_mask:0xf
  v_dot2c_f32_bf16_dpp v17, v13, v92 row_newbcast:1 row_mask:0xf bank_mask:0xf
  v_dot2c_f32_bf16_dpp v18, v12, v93 row_newbcast:1 row_mask:0xf bank_mask:0xf
  v_dot2c_f32_bf16_dpp v19, v13, v93 row_newbcast:1 row_mask:0xf bank_mask:0xf
  v_dot2c_f32_bf16_dpp v20, v12, v94 row_newbcast:1 row_mask:0xf bank_mask:0xf
  v_dot2c_f32_bf16_dpp v21, v13, v94 row_newbcast:1 row_mask:0xf bank_mask:0xf
  v_dot2c_f32_bf16_dpp v22, v12, v95 row_newbcast:1 row_mask:0xf bank_mask:0xf
  v_dot2c_f32_bf16_dpp v23, v13, v95 row_newbcast:1 row_mask:0xf bank_mask:0xf
  v_dot2c_f32_bf16_dpp v16, v12, v96 row_newbcast:2 row_mask:0xf bank_mask:0xf
  v_dot2c_f32_bf16_dpp v17, v13, v96 row_newbcast:2 row_mask:0xf bank_mask:0xf
  v_dot2c_f32_bf16_dpp v18, v12, v97 row_newbcast:2 row_mask:0xf bank_mask:0xf
  v_dot2c_f32_bf16_dpp v19, v13, v97 row_newbcast:2 row_mask:0xf bank_mask:0xf
  v_dot2c_f32_bf16_dpp v20, v12, v98 row_newbcast:2 row_mask:0xf bank_mask:0xf
  v_dot2c_f32_bf16_dpp v21, v13, v98 row_newbcast:2 row_mask:0xf bank_mask:0xf
  v_dot2c_f32_bf16_dpp v22, v12, v99 row_newbcast:2 row_mask:0xf bank_mask:0xf
  v_dot2c_f32_bf16_dpp v23, v13, v99 row_newbcast:2 row_mask:0xf bank_mask:0xf
  v_dot2c_f32_bf16_dpp v16, v12, v100 row_newbcast:3 row_mask:0xf bank_mask:0xf
  v_dot2c_f32_bf16_dpp v17, v13, v100 row_newbcast:3 row_mask:0xf bank_mask:0xf
  v_dot2c_f32_bf16_dpp v18, v12, v101 row_newbcast:3 row_mask:0xf bank_mask:0xf
  v_dot2c_f32_bf16_dpp v19, v13, v101 row_newbcast:3 row_mask:0xf bank_mask:0xf
  v_dot2c_f32_bf16_dpp v20, v12, v102 row_newbcast:3 row_mask:0xf bank_mask:0xf
  v_dot2c_f32_bf16_dpp v21, v13, v102 row_newbcast:3 row_mask:0xf bank_mask:0xf
  v_dot2c_f32_bf16_dpp v22, v12, v103 row_newbcast:3 row_mask:0xf bank_mask:0xf
  v_dot2c_f32_bf16_dpp v23, v13, v103 row_newbcast:3 row_mask:0xf bank_mask:0xf
  s_waitcnt vmcnt(3)
  buffer_load_dwordx4 v[136:139], v1, s[44:47], s52 offen offset:0 nt
  v_dot2c_f32_bf16_dpp v16, v12, v104 row_newbcast:4 row_mask:0xf bank_mask:0xf
  v_dot2c_f32_bf16_dpp v17, v13, v104 row_newbcast:4 row_mask:0xf bank_mask:0xf
  v_dot2c_f32_bf16_dpp v18, v12, v105 row_newbcast:4 row_mask:0xf bank_mask:0xf
  v_dot2c_f32_bf16_dpp v19, v13, v105 row_newbcast:4 row_mask:0xf bank_mask:0xf
  v_dot2c_f32_bf16_dpp v20, v12, v106 row_newbcast:4 row_mask:0xf bank_mask:0xf
  v_dot2c_f32_bf16_dpp v21, v13, v106 row_newbcast:4 row_mask:0xf bank_mask:0xf
  v_dot2c_f32_bf16_dpp v22, v12, v107 row_newbcast:4 row_mask:0xf bank_mask:0xf
  v_dot2c_f32_bf16_dpp v23, v13, v107 row_newbcast:4 row_mask:0xf bank_mask:0xf
  v_dot2c_f32_bf16_dpp v16, v12, v108 row_newbcast:5 row_mask:0xf bank_mask:0xf
  v_dot2c_f32_bf16_dpp v17, v13, v108 row_newbcast:5 row_mask:0xf bank_mask:0xf
  v_dot2c_f32_bf16_dpp v18, v12, v109 row_newbcast:5 row_mask:0xf bank_mask:0xf
  v_dot2c_f32_bf16_dpp v19, v13, v109 row_newbcast:5 row_mask:0xf bank_mask:0xf
  v_dot2c_f32_bf16_dpp v20, v12, v110 row_newbcast:5 row_mask:0xf bank_mask:0xf
  v_dot2c_f32_bf16_dpp v21, v13, v110 row_newbcast:5 row_mask:0xf bank_mask:0xf
  v_dot2c_f32_bf16_dpp v22, v12, v111 row_newbcast:5 row_mask:0xf bank_mask:0xf
  v_dot2c_f32_bf16_dpp v23, v13, v111 row_newbcast:5 row_mask:0xf bank_mask:0xf
  v_dot2c_f32_bf16_dpp v16, v12, v112 row_newbcast:6 row_mask:0xf bank_mask:0xf
  v_dot2c_f32_bf16_dpp v17, v13, v112 row_newbcast:6 row_mask:0xf bank_mask:0xf
  v_dot2c_f32_bf16_dpp v18, v12, v113 row_newbcast:6 row_mask:0xf bank_mask:0xf
  v_dot2c_f32_bf16_dpp v19, v13, v113 row_newbcast:6 row_mask:0xf bank_mask:0xf
  v_dot2c_f32_bf16_dpp v20, v12, v114 row_newbcast:6 row_mask:0xf bank_mask:0xf
  v_dot2c_f32_bf16_dpp v21, v13, v114 row_newbcast:6 row_mask:0xf bank_mask:0xf
  v_dot2c_f32_bf16_dpp v22, v12, v115 row_newbcast:6 row_mask:0xf bank_mask:0xf
  v_dot2c_f32_bf16_dpp v23, v13, v115 row_newbcast:6 row_mask:0xf bank_mask:0xf
  v_dot2c_f32_bf16_dpp v16, v12, v116 row_newbcast:7 row_mask:0xf bank_mask:0xf
  v_dot2c_f32_bf16_dpp v17, v13, v116 row_newbcast:7 row_mask:0xf bank_mask:0xf
  v_dot2c_f32_bf16_dpp v18, v12, v117 row_newbcast:7 row_mask:0xf bank_mask:0xf
  v_dot2c_f32_bf16_dpp v19, v13, v117 row_newbcast:7 row_mask:0xf bank_mask:0xf
  v_dot2c_f32_bf16_dpp v20, v12, v118 row_newbcast:7 row_mask:0xf bank_mask:0xf
  v_dot2c_f32_bf16_dpp v21, v13, v118 row_newbcast:7 row_mask:0xf bank_mask:0xf
  v_dot2c_f32_bf16_dpp v22, v12, v119 row_newbcast:7 row_mask:0xf bank_mask:0xf
  v_dot2c_f32_bf16_dpp v23, v13, v119 row_newbcast:7 row_mask:0xf bank_mask:0xf
  s_waitcnt vmcnt(3)
  buffer_load_dwordx4 v[140:143], v1, s[44:47], s52 offen offset:1024 nt
  v_dot2c_f32_bf16_dpp v16, v12, v120 row_newbcast:8 row_mask:0xf bank_mask:0xf
  v_dot2c_f32_bf16_dpp v17, v13, v120 row_newbcast:8 row_mask:0xf bank_mask:0xf
  v_dot2c_f32_bf16_dpp v18, v12, v121 row_newbcast:8 row_mask:0xf bank_mask:0xf
  v_dot2c_f32_bf16_dpp v19, v13, v121 row_newbcast:8 row_mask:0xf bank_mask:0xf
  v_dot2c_f32_bf16_dpp v20, v12, v122 row_newbcast:8 row_mask:0xf bank_mask:0xf
  v_dot2c_f32_bf16_dpp v21, v13, v122 row_newbcast:8 row_mask:0xf bank_mask:0xf
  v_dot2c_f32_bf16_dpp v22, v12, v123 row_newbcast:8 row_mask:0xf bank_mask:0xf
  v_dot2c_f32_bf16_dpp v23, v13, v123 row_newbcast:8 row_mask:0xf bank_mask:0xf
  v_dot2c_f32_bf16_dpp v16, v12, v124 row_newbcast:9 row_mask:0xf bank_mask:0xf
  v_dot2c_f32_bf16_dpp v17, v13, v124 row_newbcast:9 row_mask:0xf bank_mask:0xf
  v_dot2c_f32_bf16_dpp v18, v12, v125 row_newbcast:9 row_mask:0xf bank_mask:0xf
  v_dot2c_f32_bf16_dpp v19, v13, v125 row_newbcast:9 row_mask:0xf bank_mask:0xf
  v_dot2c_f32_bf16_dpp v20, v12, v126 row_newbcast:9 row_mask:0xf bank_mask:0xf
  v_dot2c_f32_bf16_dpp v21, v13, v126 row_newbcast:9 row_mask:0xf bank_mask:0xf
  v_dot2c_f32_bf16_dpp v22, v12, v127 row_newbcast:9 row_mask:0xf bank_mask:0xf
  v_dot2c_f32_bf16_dpp v23, v13, v127 row_newbcast:9 row_mask:0xf bank_mask:0xf
  s_waitcnt vmcnt(3)
  buffer_load_dwordx4 v[144:147], v1, s[44:47], s52 offen offset:2048 nt
  v_dot2c_f32_bf16_dpp v16, v12, v128 row_newbcast:10 row_mask:0xf bank_mask:0xf
  v_dot2c_f32_bf16_dpp v17, v13, v128 row_newbcast:10 row_mask:0xf bank_mask:0xf
  v_dot2c_f32_bf16_dpp v18, v12, v129 row_newbcast:10 row_mask:0xf bank_mask:0xf
  v_dot2c_f32_bf16_dpp v19, v13, v129 row_newbcast:10 row_mask:0xf bank_mask:0xf
  v_dot2c_f32_bf16_dpp v20, v12, v130 row_newbcast:10 row_mask:0xf bank_mask:0xf
  v_dot2c_f32_bf16_dpp v21, v13, v130 row_newbcast:10 row_mask:0xf bank_mask:0xf
  v_dot2c_f32_bf16_dpp v22, v12, v131 row_newbcast:10 row_mask:0xf bank_mask:0xf
  v_dot2c_f32_bf16_dpp v23, v13, v131 row_newbcast:10 row_mask:0xf bank_mask:0xf
  s_waitcnt vmcnt(3)
  buffer_load_dwordx4 v[148:151], v1, s[44:47], s52 offen offset:3072 nt
  s_mov_b64 exec, 1
  ds_add_u32 v7, v9 offset:24
  s_mov_b64 exec, -1
  v_and_b32 v3, 7, v0
  v_lshlrev_b32 v3, 3, v3
  s_mov_b32 s58, 2000000
Lsp_12:
  ds_read_b32 v2, v7 offset:4
  s_waitcnt lgkmcnt(0)
  v_readfirstlane_b32 s48, v2
  s_nop 0
  s_cmp_ge_u32 s48, 8
  s_cbranch_scc1 Lspx_13
  s_sleep 1
  s_sub_u32 s58, s58, 1
  s_cbranch_scc0 Lsp_12
Lspx_13:
  ds_read_b32 v2, v3 offset:64
  s_waitcnt lgkmcnt(0)
  s_nop 0
  v_max_f32_dpp v2, v2, v2 row_ror:4 row_mask:0xf bank_mask:0xf
  s_nop 1
  v_max_f32_dpp v2, v2, v2 row_ror:2 row_mask:0xf bank_mask:0xf
  s_nop 1
  v_max_f32_dpp v2, v2, v2 row_ror:1 row_mask:0xf bank_mask:0xf
  v_sub_f32 v15, v14, v2
  v_exp_f32 v15, v15
  v_lshlrev_b32 v5, 3, v0
  s_lshl_b32 s49, s6, 9
  v_add_u32 v4, s49, v5
  v_dot2c_f32_bf16_dpp v16, v12, v132 row_newbcast:11 row_mask:0xf bank_mask:0xf
  v_dot2c_f32_bf16_dpp v17, v13, v132 row_newbcast:11 row_mask:0xf bank_mask:0xf
  v_dot2c_f32_bf16_dpp v18, v12, v133 row_newbcast:11 row_mask:0xf bank_mask:0xf
  v_dot2c_f32_bf16_dpp v19, v13, v133 row_newbcast:11 row_mask:0xf bank_mask:0xf
  v_dot2c_f32_bf16_dpp v20, v12, v134 row_newbcast:11 row_mask:0xf bank_mask:0xf
  v_dot2c_f32_bf16_dpp v21, v13, v134 row_newbcast:11 row_mask:0xf bank_mask:0xf
  v_dot2c_f32_bf16_dpp v22, v12, v135 row_newbcast:11 row_mask:0xf bank_mask:0xf
  v_dot2c_f32_bf16_dpp v23, v13, v135 row_newbcast:11 row_mask:0xf bank_mask:0xf
  s_waitcnt vmcnt(3)
  v_dot2c_f32_bf16_dpp v16, v12, v136 row_newbcast:12 row_mask:0xf bank_mask:0xf
  v_dot2c_f32_bf16_dpp v17, v13, v136 row_newbcast:12 row_mask:0xf bank_mask:0xf
  v_dot2c_f32_bf16_dpp v18, v12, v137 row_newbcast:12 row_mask:0xf bank_mask:0xf
  v_dot2c_f32_bf16_dpp v19, v13, v137 row_newbcast:12 row_mask:0xf bank_mask:0xf
  v_dot2c_f32_bf16_dpp v20, v12, v138 row_newbcast:12 row_mask:0xf bank_mask:0xf
  v_dot2c_f32_bf16_dpp v21, v13, v138 row_newbcast:12 row_mask:0xf bank_mask:0xf
  v_dot2c_f32_bf16_dpp v22, v12, v139 row_newbcast:12 row_mask:0xf bank_mask:0xf
  v_dot2c_f32_bf16_dpp v23, v13, v139 row_newbcast:12 row_mask:0xf bank_mask:0xf
  s_waitcnt vmcnt(2)
  v_dot2c_f32_bf16_dpp v16, v12, v140 row_newbcast:13 row_mask:0xf bank_mask:0xf
  v_dot2c_f32_bf16_dpp v17, v13, v140 row_newbcast:13 row_mask:0xf bank_mask:0xf
  v_dot2c_f32_bf16_dpp v18, v12, v141 row_newbcast:13 row_mask:0xf bank_mask:0xf
  v_dot2c_f32_bf16_dpp v19, v13, v141 row_newbcast:13 row_mask:0xf bank_mask:0xf
  v_dot2c_f32_bf16_dpp v20, v12, v142 row_newbcast:13 row_mask:0xf bank_mask:0xf
  v_dot2c_f32_bf16_dpp v21, v13, v142 row_newbcast:13 row_mask:0xf bank_mask:0xf
  v_dot2c_f32_bf16_dpp v22, v12, v143 row_newbcast:13 row_mask:0xf bank_mask:0xf
  v_dot2c_f32_bf16_dpp v23, v13, v143 row_newbcast:13 row_mask:0xf bank_mask:0xf
  s_waitcnt vmcnt(1)
  v_dot2c_f32_bf16_dpp v16, v12, v144 row_newbcast:14 row_mask:0xf bank_mask:0xf
  v_dot2c_f32_bf16_dpp v17, v13, v144 row_newbcast:14 row_mask:0xf bank_mask:0xf
  v_dot2c_f32_bf16_dpp v18, v12, v145 row_newbcast:14 row_mask:0xf bank_mask:0xf
  v_dot2c_f32_bf16_dpp v19, v13, v145 row_newbcast:14 row_mask:0xf bank_mask:0xf
  v_dot2c_f32_bf16_dpp v20, v12, v146 row_newbcast:14 row_mask:0xf bank_mask:0xf
  v_dot2c_f32_bf16_dpp v21, v13, v146 row_newbcast:14 row_mask:0xf bank_mask:0xf
  v_dot2c_f32_bf16_dpp v22, v12, v147 row_newbcast:14 row_mask:0xf bank_mask:0xf
  v_dot2c_f32_bf16_dpp v23, v13, v147 row_newbcast:14 row_mask:0xf bank_mask:0xf
  s_waitcnt vmcnt(0)
  v_dot2c_f32_bf16_dpp v16, v12, v148 row_newbcast:15 row_mask:0xf bank_mask:0xf
  v_dot2c_f32_bf16_dpp v17, v13, v148 row_newbcast:15 row_mask:0xf bank_mask:0xf
  v_dot2c_f32_bf16_dpp v18, v12, v149 row_newbcast:15 row_mask:0xf bank_mask:0xf
  v_dot2c_f32_bf16_dpp v19, v13, v149 row_newbcast:15 row_mask:0xf bank_mask:0xf
  v_dot2c_f32_bf16_dpp v20, v12, v150 row_newbcast:15 row_mask:0xf bank_mask:0xf
  v_dot2c_f32_bf16_dpp v21, v13, v150 row_newbcast:15 row_mask:0xf bank_mask:0xf
  v_dot2c_f32_bf16_dpp v22, v12, v151 row_newbcast:15 row_mask:0xf bank_mask:0xf
  v_dot2c_f32_bf16_dpp v23, v13, v151 row_newbcast:15 row_mask:0xf bank_mask:0xf
  v_permlane32_swap_b32 v16, v20
  v_permlane32_swap_b32 v17, v21
  v_permlane32_swap_b32 v18, v22
  v_permlane32_swap_b32 v19, v23
  v_add_f32 v16, v16, v20
  v_add_f32 v17, v17, v21
  v_add_f32 v18, v18, v22
  v_add_f32 v19, v19, v23
  s_nop 0
  v_permlane16_swap_b32 v16, v18
  v_permlane16_swap_b32 v17, v19
  v_add_f32 v16, v16, v18
  v_add_f32 v17, v17, v19
  v_mul_f32 v16, v16, v15
  v_mul_f32 v17, v17, v15
  ds_write_b64 v4, v[16:17] offset:2048
  s_mov_b64 exec, 1
  ds_add_rtn_u32 v2, v7, v9 offset:8
  s_mov_b64 exec, -1
  ds_read2st64_b64 v[24:27], v5 offset0:4 offset1:5
  ds_read2st64_b64 v[28:31], v5 offset0:6 offset1:7
  ds_read2st64_b64 v[32:35], v5 offset0:8 offset1:9
  ds_read2st64_b64 v[36:39], v5 offset0:10 offset1:11
  s_waitcnt lgkmcnt(4)
  v_readfirstlane_b32 s48, v2
  s_nop 0
  s_cmp_lg_u32 s48, 7
  s_cbranch_scc1 L_notlast
  s_waitcnt lgkmcnt(2)
  v_pk_add_f32 v[24:25], v[24:25], v[26:27]
  v_pk_add_f32 v[28:29], v[28:29], v[30:31]
  v_pk_add_f32 v[24:25], v[24:25], v[28:29]
  s_waitcnt lgkmcnt(0)
  v_pk_add_f32 v[32:33], v[32:33], v[34:35]
  v_pk_add_f32 v[36:37], v[36:37], v[38:39]
  v_pk_add_f32 v[24:25], v[24:25], v[32:33]
  v_pk_add_f32 v[24:25], v[24:25], v[36:37]
  s_cmp_eq_u32 s7, 1
  s_cbranch_scc0 Lms_14
  buffer_store_dwordx2 v[24:25], v6, s[8:11], s51 offen
  s_branch Lmx_15
Lms_14:
  buffer_store_dwordx2 v[24:25], v6, s[8:11], s51 offen sc1
Lmx_15:
  ds_write_b32 v7, v9 offset:16
  s_endpgm
L_notlast:
L_end3:
L_last:
  s_endpgm
.section .rodata,"a"
.p2align 6
.amdhsa_kernel recurrent_scan__sliding_block_cached__swiglu_ffn__decode_kernel
  .amdhsa_next_free_vgpr 152
  .amdhsa_next_free_sgpr 100
  .amdhsa_accum_offset 152
  .amdhsa_group_segment_fixed_size 0
  .amdhsa_kernarg_size 96
  .amdhsa_user_sgpr_count 2
  .amdhsa_user_sgpr_kernarg_segment_ptr 1
  .amdhsa_system_sgpr_workgroup_id_x 1
.end_amdhsa_kernel
```
